```python
import torch

def _softmax(x, axis=-1):
    return torch.softmax(x, dim=axis)
def _gelu(x):
    return torch.nn.functional.gelu(x, approximate="tanh")
def _silu(x):
    return torch.nn.functional.silu(x)
def _sigmoid(x):
    return torch.sigmoid(x)
def _layernorm(x, axis=-1, eps=1e-5):
    m = x.mean(dim=axis, keepdim=True)
    v = x.var(dim=axis, keepdim=True, unbiased=False)
    return (x - m) / torch.sqrt(v + eps)
def _scatter_add(tgt, idx, src, axis=0):
    return tgt.clone().index_add_(axis, idx, src)
def _segment_sum(src, seg, n):
    out = torch.zeros((n,) + src.shape[1:], dtype=src.dtype)
    return out.index_add_(0, seg, src)
def _pad(x, pw):
    flat = tuple(v for pair in reversed(pw) for v in pair)
    return torch.nn.functional.pad(x, flat)

kernel_name = 'standalone__glu_gated_glu__decode'

def setup_inputs():

    _w = (lambda a: (lambda t: t.to(torch.bfloat16) if t.is_floating_point() else t)(torch.as_tensor(a)))
    B, S, D, F = 4, 1, 1024, 3584
    return {
        "x": _w((lambda *s: torch.randn(*s, dtype=torch.bfloat16) * 0.1)(B, S, D)),
        "w_gate": _w((lambda *s: torch.randn(*s, dtype=torch.bfloat16) * 0.1)(D, F)),
        "w_up": _w((lambda *s: torch.randn(*s, dtype=torch.bfloat16) * 0.05)(D, F)),
        "w_down": _w((lambda *s: torch.randn(*s, dtype=torch.bfloat16) * 0.05)(F, D)),
    }

def reference(x, w_gate, w_up, w_down):
    g = torch.einsum("bsd,df->bsf", x, w_gate)
    u = torch.einsum("bsd,df->bsf", x, w_up)
    h = _sigmoid(g) * u
    return torch.einsum("bsf,fd->bsd", h, w_down)
```

```asm
; @launch grid=(224,1,1) block=(256,1,1) lds=9216
.amdgcn_target "amdgcn-amd-amdhsa--gfx950"
.text
.globl standalone__glu_gated_glu__decode_kernel
.p2align 8
.type standalone__glu_gated_glu__decode_kernel,@function
standalone__glu_gated_glu__decode_kernel:
  s_cmp_ge_u32 s2, 224
  s_cbranch_scc1 L_end
  s_load_dwordx8 s[4:11], s[0:1], 0
  s_load_dwordx4 s[12:15], s[0:1], 32
  s_load_dwordx2 s[16:17], s[0:1], 48
  v_and_b32 v1, 63, v0
  v_lshrrev_b32 v2, 6, v0
  v_lshrrev_b32 v3, 4, v1
  v_readfirstlane_b32 s18, v2
  v_and_b32 v4, 15, v1
  s_lshr_b32 s19, s2, 3
  s_and_b32 s20, s2, 7
  s_and_b32 s21, s20, 3
  s_lshr_b32 s22, s20, 2
  s_lshl_b32 s23, s21, 8
  s_lshl_b32 s36, s18, 6
  s_add_u32 s23, s23, s36
  s_lshl_b32 s36, s23, 1
  s_mul_i32 s37, s23, 7168
  s_lshl_b32 s38, s19, 8
  s_add_u32 s37, s37, s38
  s_lshl_b32 s38, s19, 7
  s_lshl_b32 s39, s18, 5
  s_add_u32 s38, s38, s39
  s_lshl_b32 s38, s38, 11
  s_lshl_b32 s39, s20, 8
  s_add_u32 s38, s38, s39
  v_lshrrev_b32 v5, 2, v4
  v_lshlrev_b32 v5, 11, v5
  v_lshl_add_u32 v5, v3, 5, v5
  s_mov_b32 s39, 114688
  v_mul_lo_u32 v6, v3, s39
  v_lshl_add_u32 v6, v4, 4, v6
  v_lshlrev_b32 v7, 14, v3
  v_lshl_add_u32 v7, v4, 4, v7
  s_waitcnt lgkmcnt(0)
  s_cmp_eq_u32 s22, 0
  s_cselect_b32 s24, s6, s8
  s_cselect_b32 s25, s7, s9
  s_mov_b32 s26, 7340032
  s_mov_b32 s27, 0x00020000
  s_mov_b32 s32, s4
  s_mov_b32 s33, s5
  s_mov_b32 s34, 8192
  s_mov_b32 s35, 0x00020000
  buffer_load_dwordx4 v[8:11], v5, s[32:35], s36 offen
  buffer_load_dwordx4 v[12:15], v5, s[32:35], s36 offen offset:16
  buffer_load_dwordx4 v[64:67], v6, s[24:27], s37 offen nt
  s_add_u32 s37, s37, 7168
  buffer_load_dwordx4 v[68:71], v6, s[24:27], s37 offen nt
  s_add_u32 s37, s37, 7168
  buffer_load_dwordx4 v[72:75], v6, s[24:27], s37 offen nt
  s_add_u32 s37, s37, 7168
  buffer_load_dwordx4 v[76:79], v6, s[24:27], s37 offen nt
  s_add_u32 s37, s37, 7168
  buffer_load_dwordx4 v[80:83], v6, s[24:27], s37 offen nt
  s_add_u32 s37, s37, 7168
  buffer_load_dwordx4 v[84:87], v6, s[24:27], s37 offen nt
  s_add_u32 s37, s37, 7168
  buffer_load_dwordx4 v[88:91], v6, s[24:27], s37 offen nt
  s_add_u32 s37, s37, 7168
  buffer_load_dwordx4 v[92:95], v6, s[24:27], s37 offen nt
  s_add_u32 s37, s37, 7168
  buffer_load_dwordx4 v[96:99], v6, s[24:27], s37 offen nt
  s_add_u32 s37, s37, 7168
  buffer_load_dwordx4 v[100:103], v6, s[24:27], s37 offen nt
  s_add_u32 s37, s37, 7168
  buffer_load_dwordx4 v[104:107], v6, s[24:27], s37 offen nt
  s_add_u32 s37, s37, 7168
  buffer_load_dwordx4 v[108:111], v6, s[24:27], s37 offen nt
  s_add_u32 s37, s37, 7168
  buffer_load_dwordx4 v[112:115], v6, s[24:27], s37 offen nt
  s_add_u32 s37, s37, 7168
  buffer_load_dwordx4 v[116:119], v6, s[24:27], s37 offen nt
  s_add_u32 s37, s37, 7168
  buffer_load_dwordx4 v[120:123], v6, s[24:27], s37 offen nt
  s_add_u32 s37, s37, 7168
  buffer_load_dwordx4 v[124:127], v6, s[24:27], s37 offen nt
  s_add_u32 s48, s16, 2097088
  s_addc_u32 s49, s17, 0
  s_load_dwordx2 s[44:45], s[48:49], 0
  s_mov_b32 s28, s10
  s_mov_b32 s29, s11
  s_mov_b32 s30, 7340032
  s_mov_b32 s31, 0x00020000
  v_and_b32 v16, 3, v4
  v_mov_b32 v17, 0x0c0c0c0c
  v_mov_b32 v18, 0x0c0c0100
  v_mov_b32 v19, 0x01000c0c
  v_cmp_eq_u32 s[40:41], 0, v16
  v_cmp_eq_u32 s[42:43], 1, v16
  v_cmp_eq_u32 s[50:51], 2, v16
  v_cmp_eq_u32 s[46:47], 3, v16
  s_nop 1
  v_cndmask_b32 v56, v17, v18, s[40:41]
  v_cndmask_b32 v56, v56, v19, s[42:43]
  v_cndmask_b32 v58, v17, v18, s[50:51]
  v_cndmask_b32 v58, v58, v19, s[46:47]
  v_mov_b32 v18, 0x0c0c0302
  v_mov_b32 v19, 0x03020c0c
  v_cndmask_b32 v57, v17, v18, s[40:41]
  v_cndmask_b32 v57, v57, v19, s[42:43]
  v_cndmask_b32 v59, v17, v18, s[50:51]
  v_cndmask_b32 v59, v59, v19, s[46:47]
  v_mov_b32 v48, 0
  v_mov_b32 v49, 0
  v_mov_b32 v50, 0
  v_mov_b32 v51, 0
  v_mov_b32 v52, 0
  v_mov_b32 v53, 0
  v_mov_b32 v54, 0
  v_mov_b32 v55, 0
  v_lshlrev_b32 v60, 4, v1
  s_lshl_b32 s40, s18, 11
  v_add_u32 v60, s40, v60
  v_lshlrev_b32 v61, 3, v0
  s_lshl_b32 s40, s2, 12
  v_lshlrev_b32 v63, 4, v0
  v_add_u32 v62, s40, v63
  s_waitcnt vmcnt(16)
  v_perm_b32 v16, v8, v8, v56
  v_perm_b32 v17, v8, v8, v58
  v_perm_b32 v18, v8, v8, v57
  v_perm_b32 v19, v8, v8, v59
  v_perm_b32 v20, v9, v9, v56
  v_perm_b32 v21, v9, v9, v58
  v_perm_b32 v22, v9, v9, v57
  v_perm_b32 v23, v9, v9, v59
  v_perm_b32 v24, v10, v10, v56
  v_perm_b32 v25, v10, v10, v58
  v_perm_b32 v26, v10, v10, v57
  v_perm_b32 v27, v10, v10, v59
  v_perm_b32 v28, v11, v11, v56
  v_perm_b32 v29, v11, v11, v58
  v_perm_b32 v30, v11, v11, v57
  v_perm_b32 v31, v11, v11, v59
  v_perm_b32 v32, v12, v12, v56
  v_perm_b32 v33, v12, v12, v58
  v_perm_b32 v34, v12, v12, v57
  v_perm_b32 v35, v12, v12, v59
  v_perm_b32 v36, v13, v13, v56
  v_perm_b32 v37, v13, v13, v58
  v_perm_b32 v38, v13, v13, v57
  v_perm_b32 v39, v13, v13, v59
  v_perm_b32 v40, v14, v14, v56
  v_perm_b32 v41, v14, v14, v58
  v_perm_b32 v42, v14, v14, v57
  v_perm_b32 v43, v14, v14, v59
  v_perm_b32 v44, v15, v15, v56
  v_perm_b32 v45, v15, v15, v58
  v_perm_b32 v46, v15, v15, v57
  v_perm_b32 v47, v15, v15, v59
  s_waitcnt lgkmcnt(0)
  s_add_u32 s44, s44, 0x7f4a7c15
  s_addc_u32 s45, s45, 0x9e3779b9
  v_mov_b32 v10, s44
  v_mov_b32 v11, s45
  s_waitcnt vmcnt(15)
  v_mfma_f32_16x16x16_bf16 v[48:51], v[16:17], v[64:65], v[48:51]
  v_mfma_f32_16x16x16_bf16 v[52:55], v[16:17], v[66:67], v[52:55]
  s_waitcnt vmcnt(14)
  v_mfma_f32_16x16x16_bf16 v[48:51], v[18:19], v[68:69], v[48:51]
  v_mfma_f32_16x16x16_bf16 v[52:55], v[18:19], v[70:71], v[52:55]
  s_waitcnt vmcnt(13)
  v_mfma_f32_16x16x16_bf16 v[48:51], v[20:21], v[72:73], v[48:51]
  v_mfma_f32_16x16x16_bf16 v[52:55], v[20:21], v[74:75], v[52:55]
  s_waitcnt vmcnt(12)
  v_mfma_f32_16x16x16_bf16 v[48:51], v[22:23], v[76:77], v[48:51]
  v_mfma_f32_16x16x16_bf16 v[52:55], v[22:23], v[78:79], v[52:55]
  s_waitcnt vmcnt(11)
  v_mfma_f32_16x16x16_bf16 v[48:51], v[24:25], v[80:81], v[48:51]
  v_mfma_f32_16x16x16_bf16 v[52:55], v[24:25], v[82:83], v[52:55]
  s_waitcnt vmcnt(10)
  v_mfma_f32_16x16x16_bf16 v[48:51], v[26:27], v[84:85], v[48:51]
  v_mfma_f32_16x16x16_bf16 v[52:55], v[26:27], v[86:87], v[52:55]
  s_waitcnt vmcnt(9)
  v_mfma_f32_16x16x16_bf16 v[48:51], v[28:29], v[88:89], v[48:51]
  v_mfma_f32_16x16x16_bf16 v[52:55], v[28:29], v[90:91], v[52:55]
  s_waitcnt vmcnt(8)
  v_mfma_f32_16x16x16_bf16 v[48:51], v[30:31], v[92:93], v[48:51]
  v_mfma_f32_16x16x16_bf16 v[52:55], v[30:31], v[94:95], v[52:55]
  s_waitcnt vmcnt(7)
  v_mfma_f32_16x16x16_bf16 v[48:51], v[32:33], v[96:97], v[48:51]
  v_mfma_f32_16x16x16_bf16 v[52:55], v[32:33], v[98:99], v[52:55]
  buffer_load_dwordx4 v[128:131], v7, s[28:31], s38 offen offset:0 nt
  s_waitcnt vmcnt(7)
  v_mfma_f32_16x16x16_bf16 v[48:51], v[34:35], v[100:101], v[48:51]
  v_mfma_f32_16x16x16_bf16 v[52:55], v[34:35], v[102:103], v[52:55]
  buffer_load_dwordx4 v[132:135], v7, s[28:31], s38 offen offset:2048 nt
  s_add_u32 s38, s38, 4096
  s_waitcnt vmcnt(7)
  v_mfma_f32_16x16x16_bf16 v[48:51], v[36:37], v[104:105], v[48:51]
  v_mfma_f32_16x16x16_bf16 v[52:55], v[36:37], v[106:107], v[52:55]
  buffer_load_dwordx4 v[136:139], v7, s[28:31], s38 offen offset:0 nt
  s_waitcnt vmcnt(7)
  v_mfma_f32_16x16x16_bf16 v[48:51], v[38:39], v[108:109], v[48:51]
  v_mfma_f32_16x16x16_bf16 v[52:55], v[38:39], v[110:111], v[52:55]
  buffer_load_dwordx4 v[140:143], v7, s[28:31], s38 offen offset:2048 nt
  s_add_u32 s38, s38, 4096
  s_waitcnt vmcnt(7)
  v_mfma_f32_16x16x16_bf16 v[48:51], v[40:41], v[112:113], v[48:51]
  v_mfma_f32_16x16x16_bf16 v[52:55], v[40:41], v[114:115], v[52:55]
  buffer_load_dwordx4 v[144:147], v7, s[28:31], s38 offen offset:0 nt
  s_waitcnt vmcnt(7)
  v_mfma_f32_16x16x16_bf16 v[48:51], v[42:43], v[116:117], v[48:51]
  v_mfma_f32_16x16x16_bf16 v[52:55], v[42:43], v[118:119], v[52:55]
  buffer_load_dwordx4 v[148:151], v7, s[28:31], s38 offen offset:2048 nt
  s_add_u32 s38, s38, 4096
  s_waitcnt vmcnt(7)
  v_mfma_f32_16x16x16_bf16 v[48:51], v[44:45], v[120:121], v[48:51]
  v_mfma_f32_16x16x16_bf16 v[52:55], v[44:45], v[122:123], v[52:55]
  buffer_load_dwordx4 v[152:155], v7, s[28:31], s38 offen offset:0 nt
  s_waitcnt vmcnt(7)
  v_mfma_f32_16x16x16_bf16 v[48:51], v[46:47], v[124:125], v[48:51]
  v_mfma_f32_16x16x16_bf16 v[52:55], v[46:47], v[126:127], v[52:55]
  buffer_load_dwordx4 v[156:159], v7, s[28:31], s38 offen offset:2048 nt
  s_lshl_b32 s41, s19, 15
  v_add_u32 v20, s41, v63
  v_add_u32 v21, 4096, v20
  v_add_u32 v22, 4096, v21
  v_add_u32 v23, 4096, v22
  v_add_u32 v24, 4096, v23
  v_add_u32 v25, 4096, v24
  v_add_u32 v26, 4096, v25
  v_add_u32 v27, 4096, v26
  ds_write_b128 v60, v[48:51]
  ds_write_b128 v60, v[52:55] offset:1024
  s_waitcnt lgkmcnt(0)
  s_barrier
  ds_read_b64 v[32:33], v61
  ds_read_b64 v[34:35], v61 offset:2048
  ds_read_b64 v[36:37], v61 offset:4096
  ds_read_b64 v[38:39], v61 offset:6144
  s_waitcnt lgkmcnt(0)
  v_add_f32 v32, v32, v34
  v_add_f32 v33, v33, v35
  v_add_f32 v36, v36, v38
  v_add_f32 v37, v37, v39
  v_add_f32 v8, v32, v36
  v_add_f32 v9, v33, v37
  global_store_dwordx4 v62, v[8:11], s[16:17] sc1
  s_cmp_lg_u32 s20, 0
  s_cbranch_scc1 L_nf0
  v_mov_b32 v64, v8
  v_mov_b32 v65, v9
  v_mov_b32 v66, v10
  v_mov_b32 v67, v11
L_nf0:
  s_cmp_lg_u32 s20, 1
  s_cbranch_scc1 L_nf1
  v_mov_b32 v68, v8
  v_mov_b32 v69, v9
  v_mov_b32 v70, v10
  v_mov_b32 v71, v11
L_nf1:
  s_cmp_lg_u32 s20, 2
  s_cbranch_scc1 L_nf2
  v_mov_b32 v72, v8
  v_mov_b32 v73, v9
  v_mov_b32 v74, v10
  v_mov_b32 v75, v11
L_nf2:
  s_cmp_lg_u32 s20, 3
  s_cbranch_scc1 L_nf3
  v_mov_b32 v76, v8
  v_mov_b32 v77, v9
  v_mov_b32 v78, v10
  v_mov_b32 v79, v11
L_nf3:
  s_cmp_lg_u32 s20, 4
  s_cbranch_scc1 L_nf4
  v_mov_b32 v80, v8
  v_mov_b32 v81, v9
  v_mov_b32 v82, v10
  v_mov_b32 v83, v11
L_nf4:
  s_cmp_lg_u32 s20, 5
  s_cbranch_scc1 L_nf5
  v_mov_b32 v84, v8
  v_mov_b32 v85, v9
  v_mov_b32 v86, v10
  v_mov_b32 v87, v11
L_nf5:
  s_cmp_lg_u32 s20, 6
  s_cbranch_scc1 L_nf6
  v_mov_b32 v88, v8
  v_mov_b32 v89, v9
  v_mov_b32 v90, v10
  v_mov_b32 v91, v11
L_nf6:
  s_cmp_lg_u32 s20, 7
  s_cbranch_scc1 L_nf7
  v_mov_b32 v92, v8
  v_mov_b32 v93, v9
  v_mov_b32 v94, v10
  v_mov_b32 v95, v11
L_nf7:
  v_bfe_u32 v14, v0, 5, 2
  v_lshlrev_b32 v14, 8, v14
  v_bfe_u32 v15, v0, 1, 4
  v_lshl_add_u32 v14, v15, 4, v14
  v_lshrrev_b32 v15, 7, v0
  v_lshl_add_u32 v14, v15, 3, v14
  v_and_b32 v15, 1, v0
  v_lshl_add_u32 v14, v15, 2, v14
  v_lshrrev_b32 v5, 2, v4
  v_lshlrev_b32 v5, 8, v5
  v_lshl_add_u32 v5, v3, 4, v5
  s_lshl_b32 s40, s18, 6
  v_add_u32 v5, s40, v5
  v_mov_b32 v48, 0
  v_mov_b32 v49, 0
  v_mov_b32 v50, 0
  v_mov_b32 v51, 0
  v_mov_b32 v52, 0
  v_mov_b32 v53, 0
  v_mov_b32 v54, 0
  v_mov_b32 v55, 0
  v_add_u32 v62, 1048576, v62
  s_waitcnt vmcnt(0)
  s_mov_b32 s59, 0
  s_cmp_eq_u32 s20, 0
  s_cselect_b32 s60, 1, 0
  s_cmp_eq_u32 s20, 1
  s_cselect_b32 s61, 1, 0
  s_cmp_eq_u32 s20, 2
  s_cselect_b32 s62, 1, 0
  s_cmp_eq_u32 s20, 3
  s_cselect_b32 s63, 1, 0
  s_cmp_eq_u32 s20, 4
  s_cselect_b32 s64, 1, 0
  s_cmp_eq_u32 s20, 5
  s_cselect_b32 s65, 1, 0
  s_cmp_eq_u32 s20, 6
  s_cselect_b32 s66, 1, 0
  s_cmp_eq_u32 s20, 7
  s_cselect_b32 s67, 1, 0
L_poll1:
  s_cmp_eq_u32 s60, 1
  s_cbranch_scc1 L_own0
  global_load_dwordx4 v[64:67], v20, s[16:17] sc1
L_own0:
  s_cmp_eq_u32 s61, 1
  s_cbranch_scc1 L_own1
  global_load_dwordx4 v[68:71], v21, s[16:17] sc1
L_own1:
  s_cmp_eq_u32 s62, 1
  s_cbranch_scc1 L_own2
  global_load_dwordx4 v[72:75], v22, s[16:17] sc1
L_own2:
  s_cmp_eq_u32 s63, 1
  s_cbranch_scc1 L_own3
  global_load_dwordx4 v[76:79], v23, s[16:17] sc1
L_own3:
  s_cmp_eq_u32 s64, 1
  s_cbranch_scc1 L_own4
  global_load_dwordx4 v[80:83], v24, s[16:17] sc1
L_own4:
  s_cmp_eq_u32 s65, 1
  s_cbranch_scc1 L_own5
  global_load_dwordx4 v[84:87], v25, s[16:17] sc1
L_own5:
  s_cmp_eq_u32 s66, 1
  s_cbranch_scc1 L_own6
  global_load_dwordx4 v[88:91], v26, s[16:17] sc1
L_own6:
  s_cmp_eq_u32 s67, 1
  s_cbranch_scc1 L_own7
  global_load_dwordx4 v[92:95], v27, s[16:17] sc1
L_own7:
  s_waitcnt vmcnt(0)
  s_mov_b32 s46, 0
  v_cmp_ne_u64 vcc, s[44:45], v[66:67]
  s_cmp_eq_u64 vcc, 0
  s_cselect_b32 s60, 1, 0
  s_add_u32 s46, s46, s60
  v_cmp_ne_u64 vcc, s[44:45], v[70:71]
  s_cmp_eq_u64 vcc, 0
  s_cselect_b32 s61, 1, 0
  s_add_u32 s46, s46, s61
  v_cmp_ne_u64 vcc, s[44:45], v[74:75]
  s_cmp_eq_u64 vcc, 0
  s_cselect_b32 s62, 1, 0
  s_add_u32 s46, s46, s62
  v_cmp_ne_u64 vcc, s[44:45], v[78:79]
  s_cmp_eq_u64 vcc, 0
  s_cselect_b32 s63, 1, 0
  s_add_u32 s46, s46, s63
  v_cmp_ne_u64 vcc, s[44:45], v[82:83]
  s_cmp_eq_u64 vcc, 0
  s_cselect_b32 s64, 1, 0
  s_add_u32 s46, s46, s64
  v_cmp_ne_u64 vcc, s[44:45], v[86:87]
  s_cmp_eq_u64 vcc, 0
  s_cselect_b32 s65, 1, 0
  s_add_u32 s46, s46, s65
  v_cmp_ne_u64 vcc, s[44:45], v[90:91]
  s_cmp_eq_u64 vcc, 0
  s_cselect_b32 s66, 1, 0
  s_add_u32 s46, s46, s66
  v_cmp_ne_u64 vcc, s[44:45], v[94:95]
  s_cmp_eq_u64 vcc, 0
  s_cselect_b32 s67, 1, 0
  s_add_u32 s46, s46, s67
  s_cmp_eq_u32 s46, 8
  s_cbranch_scc1 L_got1
  s_add_u32 s59, s59, 1
  s_cmp_lt_u32 s59, 0x100000
  s_cbranch_scc1 L_poll1
  s_endpgm
L_got1:
  v_add_f32 v64, v64, v68
  v_add_f32 v65, v65, v69
  v_add_f32 v72, v72, v76
  v_add_f32 v73, v73, v77
  v_add_f32 v80, v80, v84
  v_add_f32 v81, v81, v85
  v_add_f32 v88, v88, v92
  v_add_f32 v89, v89, v93
  v_add_f32 v32, v64, v72
  v_add_f32 v33, v65, v73
  v_add_f32 v48, v80, v88
  v_add_f32 v49, v81, v89
  v_cvt_pk_bf16_f32 v32, v32, v33
  v_cvt_pk_bf16_f32 v48, v48, v49
  v_lshlrev_b32 v33, 16, v32
  v_and_b32 v34, 0xffff0000, v32
  v_mul_f32 v33, 0xbfb8aa3b, v33
  v_mul_f32 v34, 0xbfb8aa3b, v34
  v_exp_f32 v33, v33
  v_exp_f32 v34, v34
  v_lshlrev_b32 v35, 16, v48
  v_add_f32 v33, 1.0, v33
  v_add_f32 v34, 1.0, v34
  v_rcp_f32 v33, v33
  v_rcp_f32 v34, v34
  v_and_b32 v36, 0xffff0000, v48
  v_cvt_pk_bf16_f32 v32, v33, v34
  v_mov_b32 v48, 0
  v_lshlrev_b32 v33, 16, v32
  v_and_b32 v34, 0xffff0000, v32
  v_mov_b32 v49, 0
  v_mul_f32 v33, v33, v35
  v_mul_f32 v34, v34, v36
  v_cvt_pk_bf16_f32 v32, v33, v34
  ds_write_b32 v14, v32 offset:8192
  s_waitcnt lgkmcnt(0)
  s_barrier
  ds_read_b128 v[32:35], v5 offset:8192
  s_waitcnt lgkmcnt(0)
  v_perm_b32 v16, v32, v32, v56
  v_perm_b32 v17, v32, v32, v58
  v_perm_b32 v18, v32, v32, v57
  v_perm_b32 v19, v32, v32, v59
  v_perm_b32 v20, v33, v33, v56
  v_perm_b32 v21, v33, v33, v58
  v_perm_b32 v22, v33, v33, v57
  v_perm_b32 v23, v33, v33, v59
  v_perm_b32 v24, v34, v34, v56
  v_perm_b32 v25, v34, v34, v58
  v_perm_b32 v26, v34, v34, v57
  v_perm_b32 v27, v34, v34, v59
  v_perm_b32 v28, v35, v35, v56
  v_perm_b32 v29, v35, v35, v58
  v_perm_b32 v30, v35, v35, v57
  v_perm_b32 v31, v35, v35, v59
  v_mfma_f32_16x16x16_bf16 v[48:51], v[16:17], v[128:129], v[48:51]
  v_mfma_f32_16x16x16_bf16 v[52:55], v[16:17], v[130:131], v[52:55]
  v_mfma_f32_16x16x16_bf16 v[48:51], v[18:19], v[132:133], v[48:51]
  v_mfma_f32_16x16x16_bf16 v[52:55], v[18:19], v[134:135], v[52:55]
  v_mfma_f32_16x16x16_bf16 v[48:51], v[20:21], v[136:137], v[48:51]
  v_mfma_f32_16x16x16_bf16 v[52:55], v[20:21], v[138:139], v[52:55]
  v_mfma_f32_16x16x16_bf16 v[48:51], v[22:23], v[140:141], v[48:51]
  v_mfma_f32_16x16x16_bf16 v[52:55], v[22:23], v[142:143], v[52:55]
  v_mfma_f32_16x16x16_bf16 v[48:51], v[24:25], v[144:145], v[48:51]
  v_mfma_f32_16x16x16_bf16 v[52:55], v[24:25], v[146:147], v[52:55]
  v_mfma_f32_16x16x16_bf16 v[48:51], v[26:27], v[148:149], v[48:51]
  v_mfma_f32_16x16x16_bf16 v[52:55], v[26:27], v[150:151], v[52:55]
  v_mfma_f32_16x16x16_bf16 v[48:51], v[28:29], v[152:153], v[48:51]
  v_mfma_f32_16x16x16_bf16 v[52:55], v[28:29], v[154:155], v[52:55]
  v_mfma_f32_16x16x16_bf16 v[48:51], v[30:31], v[156:157], v[48:51]
  v_mfma_f32_16x16x16_bf16 v[52:55], v[30:31], v[158:159], v[52:55]
  s_nop 7
  s_nop 1
  ds_write_b128 v60, v[48:51]
  ds_write_b128 v60, v[52:55] offset:1024
  s_waitcnt lgkmcnt(0)
  s_barrier
  ds_read_b64 v[32:33], v61
  ds_read_b64 v[34:35], v61 offset:2048
  ds_read_b64 v[36:37], v61 offset:4096
  ds_read_b64 v[38:39], v61 offset:6144
  s_waitcnt lgkmcnt(0)
  v_add_f32 v32, v32, v34
  v_add_f32 v33, v33, v35
  v_add_f32 v36, v36, v38
  v_add_f32 v37, v37, v39
  v_add_f32 v8, v32, v36
  v_add_f32 v9, v33, v37
  global_store_dwordx4 v62, v[8:11], s[16:17] sc1
  s_cmp_ge_u32 s19, 16
  s_cbranch_scc1 L_done
  s_cmp_lg_u32 s18, 0
  s_cbranch_scc1 L_done
  s_mov_b32 s40, 229376
  v_mul_lo_u32 v20, v3, s40
  v_lshl_add_u32 v20, v4, 4, v20
  s_add_u32 s21, s20, 4
  s_and_b32 s21, s21, 7
  s_lshl_b32 s40, s21, 12
  s_lshl_b32 s41, s19, 8
  s_add_u32 s40, s40, s41
  s_add_u32 s40, s40, 1048576
  v_add_u32 v20, s40, v20
  v_add_u32 v21, 32768, v20
  v_add_u32 v22, 32768, v21
  v_add_u32 v23, 32768, v22
  v_add_u32 v24, 32768, v23
  v_add_u32 v25, 32768, v24
  v_add_u32 v26, 32768, v25
  s_lshl_b32 s40, s19, 4
  v_add_u32 v5, s40, v4
  v_bfe_u32 v14, v5, 5, 2
  v_lshlrev_b32 v14, 11, v14
  v_bfe_u32 v15, v5, 1, 4
  v_lshl_add_u32 v14, v15, 4, v14
  v_lshrrev_b32 v15, 7, v5
  v_lshl_add_u32 v14, v15, 3, v14
  v_and_b32 v15, 1, v5
  v_lshl_add_u32 v14, v15, 2, v14
  s_lshl_b32 s40, s21, 8
  v_add_u32 v14, s40, v14
  s_mov_b32 s59, 0
  global_load_dwordx4 v[64:67], v20, s[16:17] sc1
  global_load_dwordx4 v[68:71], v21, s[16:17] sc1
  global_load_dwordx4 v[72:75], v22, s[16:17] sc1
  global_load_dwordx4 v[76:79], v23, s[16:17] sc1
  global_load_dwordx4 v[80:83], v24, s[16:17] sc1
  global_load_dwordx4 v[84:87], v25, s[16:17] sc1
  global_load_dwordx4 v[88:91], v26, s[16:17] sc1
  s_sleep 8
  global_load_dwordx4 v[92:95], v20, s[16:17] sc1
  global_load_dwordx4 v[96:99], v21, s[16:17] sc1
  global_load_dwordx4 v[100:103], v22, s[16:17] sc1
  global_load_dwordx4 v[104:107], v23, s[16:17] sc1
  global_load_dwordx4 v[108:111], v24, s[16:17] sc1
  global_load_dwordx4 v[112:115], v25, s[16:17] sc1
  global_load_dwordx4 v[116:119], v26, s[16:17] sc1
L_poll2:
  s_waitcnt vmcnt(7)
  v_cmp_ne_u64 s[46:47], s[44:45], v[66:67]
  v_cmp_ne_u64 vcc, s[44:45], v[70:71]
  s_or_b64 s[46:47], s[46:47], vcc
  v_cmp_ne_u64 vcc, s[44:45], v[74:75]
  s_or_b64 s[46:47], s[46:47], vcc
  v_cmp_ne_u64 vcc, s[44:45], v[78:79]
  s_or_b64 s[46:47], s[46:47], vcc
  v_cmp_ne_u64 vcc, s[44:45], v[82:83]
  s_or_b64 s[46:47], s[46:47], vcc
  v_cmp_ne_u64 vcc, s[44:45], v[86:87]
  s_or_b64 s[46:47], s[46:47], vcc
  v_cmp_ne_u64 vcc, s[44:45], v[90:91]
  s_or_b64 s[46:47], s[46:47], vcc
  s_cmp_eq_u64 s[46:47], 0
  s_cbranch_scc1 L_got2_0
  global_load_dwordx4 v[64:67], v20, s[16:17] sc1
  global_load_dwordx4 v[68:71], v21, s[16:17] sc1
  global_load_dwordx4 v[72:75], v22, s[16:17] sc1
  global_load_dwordx4 v[76:79], v23, s[16:17] sc1
  global_load_dwordx4 v[80:83], v24, s[16:17] sc1
  global_load_dwordx4 v[84:87], v25, s[16:17] sc1
  global_load_dwordx4 v[88:91], v26, s[16:17] sc1
  s_waitcnt vmcnt(7)
  v_cmp_ne_u64 s[46:47], s[44:45], v[94:95]
  v_cmp_ne_u64 vcc, s[44:45], v[98:99]
  s_or_b64 s[46:47], s[46:47], vcc
  v_cmp_ne_u64 vcc, s[44:45], v[102:103]
  s_or_b64 s[46:47], s[46:47], vcc
  v_cmp_ne_u64 vcc, s[44:45], v[106:107]
  s_or_b64 s[46:47], s[46:47], vcc
  v_cmp_ne_u64 vcc, s[44:45], v[110:111]
  s_or_b64 s[46:47], s[46:47], vcc
  v_cmp_ne_u64 vcc, s[44:45], v[114:115]
  s_or_b64 s[46:47], s[46:47], vcc
  v_cmp_ne_u64 vcc, s[44:45], v[118:119]
  s_or_b64 s[46:47], s[46:47], vcc
  s_cmp_eq_u64 s[46:47], 0
  s_cbranch_scc1 L_got2_1
  global_load_dwordx4 v[92:95], v20, s[16:17] sc1
  global_load_dwordx4 v[96:99], v21, s[16:17] sc1
  global_load_dwordx4 v[100:103], v22, s[16:17] sc1
  global_load_dwordx4 v[104:107], v23, s[16:17] sc1
  global_load_dwordx4 v[108:111], v24, s[16:17] sc1
  global_load_dwordx4 v[112:115], v25, s[16:17] sc1
  global_load_dwordx4 v[116:119], v26, s[16:17] sc1
  s_add_u32 s59, s59, 1
  s_cmp_lt_u32 s59, 0x100000
  s_cbranch_scc1 L_poll2
  s_endpgm
L_got2_0:
  v_add_f32 v4, v64, v68
  v_add_f32 v5, v65, v69
  v_add_f32 v6, v72, v76
  v_add_f32 v7, v73, v77
  v_add_f32 v8, v80, v84
  v_add_f32 v9, v81, v85
  v_add_f32 v4, v4, v6
  v_add_f32 v5, v5, v7
  v_add_f32 v8, v8, v88
  v_add_f32 v9, v9, v89
  s_branch L_sum2
L_got2_1:
  v_add_f32 v4, v92, v96
  v_add_f32 v5, v93, v97
  v_add_f32 v6, v100, v104
  v_add_f32 v7, v101, v105
  v_add_f32 v8, v108, v112
  v_add_f32 v9, v109, v113
  v_add_f32 v4, v4, v6
  v_add_f32 v5, v5, v7
  v_add_f32 v8, v8, v116
  v_add_f32 v9, v9, v117
L_sum2:
  v_add_f32 v4, v4, v8
  v_add_f32 v5, v5, v9
  v_mov_b32 v6, v4
  v_mov_b32 v7, v5
  s_nop 1
  v_permlane32_swap_b32 v4, v6
  v_permlane32_swap_b32 v5, v7
  v_add_f32 v4, v4, v6
  v_add_f32 v5, v5, v7
  v_mov_b32 v6, v4
  v_mov_b32 v7, v5
  s_nop 1
  v_permlane16_swap_b32 v4, v6
  v_permlane16_swap_b32 v5, v7
  v_add_f32 v4, v4, v6
  v_add_f32 v5, v5, v7
  v_cvt_pk_bf16_f32 v32, v4, v5
  v_cmp_gt_u32 vcc, 16, v1
  s_and_saveexec_b64 s[42:43], vcc
  global_store_dword v14, v32, s[12:13]
  s_mov_b64 exec, s[42:43]
  s_cmp_lg_u32 s2, 0
  s_cbranch_scc1 L_done
  v_mov_b32 v5, 2097088
  v_cmp_eq_u32 vcc, 0, v1
  s_and_saveexec_b64 s[42:43], vcc
  global_store_dwordx2 v5, v[10:11], s[16:17]
  s_mov_b64 exec, s[42:43]
L_done:
L_end:
  s_endpgm
.section .rodata,"a"
.p2align 6
.amdhsa_kernel standalone__glu_gated_glu__decode_kernel
  .amdhsa_next_free_vgpr 192
  .amdhsa_next_free_sgpr 96
  .amdhsa_accum_offset 192
  .amdhsa_group_segment_fixed_size 0
  .amdhsa_kernarg_size 56
  .amdhsa_user_sgpr_count 2
  .amdhsa_user_sgpr_kernarg_segment_ptr 1
  .amdhsa_system_sgpr_workgroup_id_x 1
.end_amdhsa_kernel
```
